```python
import torch

def _softmax(x, axis=-1):
    return torch.softmax(x, dim=axis)
def _gelu(x):
    return torch.nn.functional.gelu(x, approximate="tanh")
def _silu(x):
    return torch.nn.functional.silu(x)
def _sigmoid(x):
    return torch.sigmoid(x)
def _layernorm(x, axis=-1, eps=1e-5):
    m = x.mean(dim=axis, keepdim=True)
    v = x.var(dim=axis, keepdim=True, unbiased=False)
    return (x - m) / torch.sqrt(v + eps)
def _scatter_add(tgt, idx, src, axis=0):
    return tgt.clone().index_add_(axis, idx, src)
def _segment_sum(src, seg, n):
    out = torch.zeros((n,) + src.shape[1:], dtype=src.dtype)
    return out.index_add_(0, seg, src)
def _pad(x, pw):
    flat = tuple(v for pair in reversed(pw) for v in pair)
    return torch.nn.functional.pad(x, flat)

kernel_name = 'recurrent_scan__sliding_block_cached__mixer_token_mlp__decode'

def setup_inputs():

    _w = (lambda a: (lambda t: t.to(torch.bfloat16) if t.is_floating_point() else t)(torch.as_tensor(a)))
    def _A_setup():
        B, Sq, D = 1, 1, 512
        Hq, Hkv, Sk, Dh = 32, 8, 65536, 128
        assert Hq % Hkv == 0, (Hq, Hkv)
        return {
            "x": _w((lambda *s: torch.randn(*s, dtype=torch.bfloat16) * 0.4)(B, Sq, D)),
            "k_cache": _w((lambda *s: torch.randn(*s, dtype=torch.bfloat16) * 1.6)(B, Hkv, Sk, Dh)),
            "v_cache": _w((lambda *s: torch.randn(*s, dtype=torch.bfloat16) * 1.6)(B, Hkv, Sk, Dh)),
            "wq": _w((lambda *s: torch.randn(*s, dtype=torch.bfloat16) * 1.6)(D, Hq * Dh) * (D ** -0.5)),
            "wo": _w((lambda *s: torch.randn(*s, dtype=torch.bfloat16) * 1.6)(Hq * Dh, D) * ((Hq * Dh) ** -0.5)),
        }
    _A_in = _A_setup()

    def _B_setup():
        B, S, D, F = 1, 1, 512, 1792
        return {
            "x": _w((lambda *s: torch.randn(*s, dtype=torch.bfloat16) * 0.4)(B, S, D)),
            "w1": _w((lambda *s: torch.randn(*s, dtype=torch.bfloat16) * 1.6)(S, F) * (S ** -0.5)),
            "b1": _w((lambda *s: torch.randn(*s, dtype=torch.bfloat16) * 1.6)(F) * 0.02),
            "w2": _w((lambda *s: torch.randn(*s, dtype=torch.bfloat16) * 1.6)(F, S) * (F ** -0.5)),
            "b2": _w((lambda *s: torch.randn(*s, dtype=torch.bfloat16) * 1.6)(S) * 0.02),
        }
    _B_in = _B_setup()

    return {
        "A_x": _A_in["x"],
        "A_k_cache": _A_in["k_cache"],
        "A_v_cache": _A_in["v_cache"],
        "A_wq": _A_in["wq"],
        "A_wo": _A_in["wo"],
        "B_x": _B_in["x"],
        "B_w1": _B_in["w1"],
        "B_b1": _B_in["b1"],
        "B_w2": _B_in["w2"],
        "B_b2": _B_in["b2"],
    }

def reference(A_x, A_k_cache, A_v_cache, A_wq, A_wo, B_x, B_w1, B_b1, B_w2, B_b2):
    def _A_ref(x, k_cache, v_cache, wq, wo):
        B, Sq, D = x.shape
        Hq, Dh = 32, 128
        Hkv, Sk = k_cache.shape[1], k_cache.shape[2]
        W = min(4096, max(256, Sk // 4))
        rep = Hq // Hkv
        q = (lambda x, *d: x.permute(*d))((x @ wq).reshape(B, Sq, Hq, Dh), 0, 2, 1, 3)
        k = (lambda x, n, axis: torch.repeat_interleave(x, n, dim=axis))(k_cache[:, :, Sk - W:, :], rep, axis=1)
        v = (lambda x, n, axis: torch.repeat_interleave(x, n, dim=axis))(v_cache[:, :, Sk - W:, :], rep, axis=1)
        scores = torch.einsum("bhqd,bhkd->bhqk", q, k) * (Dh ** -0.5)
        p = _softmax(scores, axis=-1)
        o = torch.einsum("bhqk,bhkd->bhqd", p, v)
        return (lambda x, *d: x.permute(*d))(o, 0, 2, 1, 3).reshape(B, Sq, Hq * Dh) @ wo

    def _B_ref(x, w1, b1, w2, b2):
        B, S, D = x.shape
        h = _layernorm(x, axis=-1)
        u = torch.einsum("bsd,sf->bdf", h, w1) + b1
        u = _gelu(u)
        y = torch.einsum("bdf,fs->bds", u, w2) + b2
        return (lambda x, *d: x.permute(*d))(y, 0, 2, 1)

    x = A_x
    xn = _layernorm(x, axis=-1)
    s = _A_ref(xn, A_k_cache, A_v_cache, A_wq, A_wo)
    g = _silu(_B_ref(xn, B_w1, B_b1, B_w2, B_b2))
    return x + s * g
```

```asm
; @launch grid=(256,1,1) block=(640,1,1) lds=102400
.amdgcn_target "amdgcn-amd-amdhsa--gfx950"
.text
.globl recurrent_scan__sliding_block_cached__mixer_token_mlp__decode_kernel
.p2align 8
.type recurrent_scan__sliding_block_cached__mixer_token_mlp__decode_kernel,@function
recurrent_scan__sliding_block_cached__mixer_token_mlp__decode_kernel:
s_cmp_ge_u32 s2, 256
s_cbranch_scc1 L_end
s_load_dwordx16 s[4:19], s[0:1], 0
s_load_dwordx8 s[20:27], s[0:1], 64
s_load_dwordx2 s[28:29], s[0:1], 96
v_lshrrev_b32 v2, 6, v0
s_and_b32 s30, s2, 7
v_readfirstlane_b32 s32, v2
s_lshr_b32 s31, s2, 3
s_cmp_lg_u32 s32, 0
s_cbranch_scc1 L_notloader
v_lshrrev_b32 v10, 2, v0
v_lshlrev_b32 v3, 13, v10
v_lshrrev_b32 v10, 5, v0
v_lshlrev_b32 v10, 1, v10
v_and_b32 v11, 3, v0
v_xor_b32 v10, v10, v11
v_lshl_add_u32 v3, v10, 4, v3
v_add_u32 v7, 130048, v3
v_add_u32 v20, 260096, v3
v_add_u32 v21, 390144, v3
s_and_b32 s38, s2, 0x78
s_lshl_b32 s38, s38, 3
s_and_b32 s39, s2, 0x80
s_lshl_b32 s39, s39, 14
s_add_u32 s38, s38, s39
s_lshl_b32 s39, s30, 10
s_add_u32 s38, s38, s39
s_mov_b32 m0, 4096
s_setprio 3
s_waitcnt lgkmcnt(0)
s_add_u32 s10, s10, s38
s_addc_u32 s11, s11, 0
global_load_lds_dwordx4 v3, s[10:11] nt
global_load_lds_dwordx4 v7, s[10:11] offset:1024 nt
global_load_lds_dwordx4 v20, s[10:11] offset:2048 nt
global_load_lds_dwordx4 v21, s[10:11] offset:3072 nt
s_add_u32 s10, s10, 524288
s_addc_u32 s11, s11, 0
s_add_u32 m0, m0, 4096
s_nop 0
global_load_lds_dwordx4 v3, s[10:11] nt
global_load_lds_dwordx4 v7, s[10:11] offset:1024 nt
global_load_lds_dwordx4 v20, s[10:11] offset:2048 nt
global_load_lds_dwordx4 v21, s[10:11] offset:3072 nt
s_load_dwordx8 s[64:71], s[26:27], 0
s_cmp_lg_u32 s31, 0
s_cbranch_scc1 L_l_nf
s_lshl_b32 s58, s30, 2
v_mov_b32 v30, s58
v_mov_b32 v31, 1
s_mov_b64 exec, 1
global_store_dword v30, v31, s[26:27] sc1
s_mov_b64 exec, -1
L_l_nf:
s_branch L_l2
L_notloader:
v_and_b32 v1, 63, v0
s_cmp_lg_u32 s32, 1
s_cbranch_scc1 L_worker
v_lshrrev_b32 v10, 2, v1
v_lshlrev_b32 v3, 13, v10
v_lshrrev_b32 v10, 5, v1
v_lshlrev_b32 v10, 1, v10
v_and_b32 v11, 3, v1
v_xor_b32 v10, v10, v11
v_lshl_add_u32 v3, v10, 4, v3
v_add_u32 v7, 130048, v3
v_add_u32 v20, 260096, v3
v_add_u32 v21, 390144, v3
s_and_b32 s38, s2, 0x78
s_lshl_b32 s38, s38, 3
s_and_b32 s39, s2, 0x80
s_lshl_b32 s39, s39, 14
s_add_u32 s38, s38, s39
s_lshl_b32 s39, s30, 10
s_add_u32 s38, s38, s39
s_add_u32 s38, s38, 1048576
s_mov_b32 m0, 12288
s_setprio 2
v_lshlrev_b32 v4, 4, v1
s_waitcnt lgkmcnt(0)
global_load_dwordx4 v[12:15], v4, s[4:5]
s_add_u32 s10, s10, s38
s_addc_u32 s11, s11, 0
global_load_lds_dwordx4 v3, s[10:11] nt
global_load_lds_dwordx4 v7, s[10:11] offset:1024 nt
global_load_lds_dwordx4 v20, s[10:11] offset:2048 nt
global_load_lds_dwordx4 v21, s[10:11] offset:3072 nt
s_add_u32 s10, s10, 524288
s_addc_u32 s11, s11, 0
s_add_u32 m0, m0, 4096
s_nop 0
global_load_lds_dwordx4 v3, s[10:11] nt
global_load_lds_dwordx4 v7, s[10:11] offset:1024 nt
global_load_lds_dwordx4 v20, s[10:11] offset:2048 nt
global_load_lds_dwordx4 v21, s[10:11] offset:3072 nt
v_lshlrev_b32 v3, 4, v1
s_branch L_comm
L_l2:
v_lshrrev_b32 v8, 4, v0
v_and_b32 v9, 15, v0
v_xor_b32 v10, v9, v8
v_lshlrev_b32 v10, 4, v10
v_lshl_add_u32 v4, v8, 8, v10
s_lshl_b32 s39, s30, 24
s_lshr_b32 s40, s31, 4
s_mul_i32 s40, s40, 524288
s_and_b32 s41, s31, 15
s_lshl_b32 s41, s41, 12
s_add_u32 s40, s40, s41
s_add_u32 s39, s39, s40
s_add_u32 s39, s39, 15728640
s_add_u32 s6, s6, s39
s_addc_u32 s7, s7, 0
v_xor_b32 v10, 64, v4
v_xor_b32 v11, 128, v4
v_xor_b32 v12, 192, v4
s_mov_b32 m0, 20480
s_mov_b32 s50, 4
L_l_k1:
s_waitcnt vmcnt(16)
global_load_lds_dwordx4 v4, s[6:7] nt
global_load_lds_dwordx4 v10, s[6:7] offset:1024 nt
global_load_lds_dwordx4 v11, s[6:7] offset:2048 nt
global_load_lds_dwordx4 v12, s[6:7] offset:3072 nt
s_add_u32 s6, s6, 65536
s_addc_u32 s7, s7, 0
s_add_u32 m0, m0, 4096
s_sub_u32 s50, s50, 1
s_cmp_lg_u32 s50, 0
s_cbranch_scc1 L_l_k1
s_add_u32 s8, s8, s39
s_addc_u32 s9, s9, 0
v_lshlrev_b32 v13, 1, v8
v_xor_b32 v14, v9, v13
v_lshlrev_b32 v14, 4, v14
v_lshl_add_u32 v5, v8, 8, v14
v_and_b32 v14, 7, v0
v_xor_b32 v14, v14, v13
v_lshlrev_b32 v14, 4, v14
v_lshrrev_b32 v15, 3, v0
v_lshl_add_u32 v6, v15, 10, v14
v_xor_b32 v13, 128, v5
v_add_u32 v23, 0, v5
v_add_u32 v24, 0, v13
v_add_u32 v13, 0, v13
v_add_u32 v14, 7168, v6
s_lshl_b32 s40, s30, 19
s_lshl_b32 s41, s31, 14
s_add_u32 s40, s40, s41
s_add_u32 s12, s12, s40
s_addc_u32 s13, s13, 0
v_mov_b32 v16, 2160
v_mov_b32 v17, 1
s_load_dword s33, s[28:29], 0
s_lshl_b32 s43, s30, 5
s_add_u32 s43, s43, s31
s_mul_i32 s44, s43, 2176
s_add_u32 s44, s44, 133120
v_and_b32 v19, 3, v0
v_lshlrev_b32 v20, 4, v19
v_add_u32 v20, s44, v20
v_add_u32 v21, 589824, v20
v_lshlrev_b32 v19, 5, v19
v_mov_b32 v22, 0xfff
s_waitcnt vmcnt(16)
s_barrier
s_waitcnt lgkmcnt(0)
s_add_u32 s64, s64, s65
s_add_u32 s64, s64, s66
s_add_u32 s64, s64, s67
s_add_u32 s64, s64, s68
s_add_u32 s64, s64, s69
s_add_u32 s64, s64, s70
s_add_u32 s64, s64, s71
s_cmp_ge_u32 s64, 3
s_cselect_b32 s57, 1, 0
s_mov_b32 s50, 4
L_l_k2:
s_cmp_lg_u32 s57, 0
s_cbranch_scc1 L_pl1
s_waitcnt vmcnt(16)
s_branch L_pe1
L_pl1:
s_waitcnt vmcnt(24)
L_pe1:
global_load_lds_dwordx4 v4, s[6:7] nt
global_load_lds_dwordx4 v10, s[6:7] offset:1024 nt
global_load_lds_dwordx4 v11, s[6:7] offset:2048 nt
global_load_lds_dwordx4 v12, s[6:7] offset:3072 nt
s_add_u32 s6, s6, 65536
s_addc_u32 s7, s7, 0
s_add_u32 m0, m0, 4096
s_sub_u32 s50, s50, 1
s_cmp_lg_u32 s50, 0
s_cbranch_scc1 L_l_k2
s_mov_b32 m0, 53248
s_mov_b32 s50, 4
ds_read_b32 v18, v16 offset:8
L_l_va:
s_waitcnt lgkmcnt(0)
v_readfirstlane_b32 s43, v18
ds_read_b32 v18, v16 offset:8
s_cmp_lg_u32 s43, 0
s_cbranch_scc1 L_l_va_hi
s_cmp_lg_u32 s57, 0
s_cbranch_scc1 L_pl2
s_waitcnt vmcnt(16)
s_branch L_pe2
L_pl2:
s_waitcnt vmcnt(24)
L_pe2:
s_branch L_l_va_i
L_l_va_hi:
s_cmp_lg_u32 s57, 0
s_cbranch_scc1 L_pl3
s_waitcnt vmcnt(28)
s_branch L_pe3
L_pl3:
s_waitcnt vmcnt(40)
L_pe3:
L_l_va_i:
global_load_lds_dwordx4 v5, s[8:9] nt
global_load_lds_dwordx4 v13, s[8:9] offset:1024 nt
global_load_lds_dwordx4 v23, s[8:9] offset:2048 nt
global_load_lds_dwordx4 v24, s[8:9] offset:3072 nt
s_add_u32 s8, s8, 65536
s_addc_u32 s9, s9, 0
s_add_u32 m0, m0, 4096
s_sub_u32 s50, s50, 1
s_cmp_lg_u32 s50, 0
s_cbranch_scc1 L_l_va
s_waitcnt vmcnt(16)
ds_write_b32 v16, v17 offset:12
s_mov_b32 s50, 4
ds_read_b32 v18, v16 offset:8
L_l_vb:
s_waitcnt lgkmcnt(0)
v_readfirstlane_b32 s43, v18
ds_read_b32 v18, v16 offset:8
s_cmp_lg_u32 s43, 0
s_cbranch_scc1 L_l_vb_hi
s_cmp_lg_u32 s57, 0
s_cbranch_scc1 L_pl4
s_waitcnt vmcnt(16)
s_branch L_pe4
L_pl4:
s_waitcnt vmcnt(24)
L_pe4:
s_branch L_l_vb_i
L_l_vb_hi:
s_cmp_lg_u32 s57, 0
s_cbranch_scc1 L_pl5
s_waitcnt vmcnt(28)
s_branch L_pe5
L_pl5:
s_waitcnt vmcnt(40)
L_pe5:
L_l_vb_i:
global_load_lds_dwordx4 v5, s[8:9] nt
global_load_lds_dwordx4 v13, s[8:9] offset:1024 nt
global_load_lds_dwordx4 v23, s[8:9] offset:2048 nt
global_load_lds_dwordx4 v24, s[8:9] offset:3072 nt
s_add_u32 s8, s8, 65536
s_addc_u32 s9, s9, 0
s_add_u32 m0, m0, 4096
s_sub_u32 s50, s50, 1
s_cmp_lg_u32 s50, 0
s_cbranch_scc1 L_l_vb
s_waitcnt vmcnt(8)
s_mov_b32 s45, m0
s_mov_b32 m0, 86016
s_mov_b32 s50, 4
L_l_wo:
s_waitcnt vmcnt(28)
global_load_lds_dwordx4 v6, s[12:13] nt
global_load_lds_dwordx4 v14, s[12:13] offset:1024 nt
s_add_u32 s12, s12, 128
s_addc_u32 s13, s13, 0
s_add_u32 m0, m0, 2048
s_nop 0
global_load_lds_dwordx4 v6, s[12:13] nt
global_load_lds_dwordx4 v14, s[12:13] offset:1024 nt
s_add_u32 s12, s12, 128
s_addc_u32 s13, s13, 0
s_add_u32 m0, m0, 2048
s_sub_u32 s50, s50, 1
s_cmp_lg_u32 s50, 0
s_cbranch_scc1 L_l_wo
s_mov_b32 m0, s45
s_waitcnt lgkmcnt(0)
s_add_u32 s33, s33, 0x1010101
s_cmp_eq_u32 s33, 0
s_cselect_b32 s33, 0x1010101, s33
s_lshr_b32 s34, s33, 8
s_lshr_b32 s35, s33, 16
s_lshr_b32 s36, s33, 24
s_lshl_b32 s37, s33, 8
s_or_b32 s36, s36, s37
s_waitcnt vmcnt(16)
s_barrier
ds_read_b128 v[32:35], v19 offset:3584
ds_read_b128 v[36:39], v19 offset:3600
ds_read_b128 v[40:43], v19 offset:3712
ds_read_b128 v[44:47], v19 offset:3728
s_waitcnt lgkmcnt(2)
v_max3_f32 v32, v32, v33, v34
v_max3_f32 v32, v32, v35, v36
v_max3_f32 v32, v32, v37, v38
v_max_f32 v32, v32, v39
s_waitcnt lgkmcnt(0)
v_pk_add_f32 v[40:41], v[40:41], v[42:43]
v_pk_add_f32 v[44:45], v[44:45], v[46:47]
v_pk_add_f32 v[40:41], v[40:41], v[44:45]
v_add_f32 v33, v40, v41
v_mov_b32 v34, 0
v_mov_b32 v35, 0
v_bfi_b32 v32, v22, s33, v32
v_bfi_b32 v33, v22, s34, v33
v_bfi_b32 v34, v22, s35, v34
v_bfi_b32 v35, v22, s36, v35
s_mov_b64 exec, 0xf
global_store_dwordx4 v20, v[32:35], s[28:29]
global_store_dwordx4 v21, v[32:35], s[28:29] sc1
s_mov_b64 exec, -1
s_waitcnt vmcnt(2)
ds_write_b32 v16, v17 offset:28
s_waitcnt lgkmcnt(0)
s_barrier
s_branch L_end
L_worker:
s_sub_u32 s32, s32, 2
v_lshrrev_b32 v8, 4, v1
v_and_b32 v9, 15, v1
v_mov_b32 v20, 0
v_mov_b32 v21, 0
v_mov_b32 v22, 0
v_mov_b32 v23, 0
v_mov_b32 v24, 0
v_mov_b32 v25, 0
s_mul_i32 s43, s32, 448
v_lshlrev_b32 v26, 3, v1
v_add_u32 v26, s43, v26
s_lshl_b32 s41, s32, 11
s_lshl_b32 s42, s32, 12
s_lshl_b32 s43, s30, 5
s_add_u32 s43, s43, s31
s_mul_i32 s44, s43, 2176
s_add_u32 s44, s44, 131072
s_lshl_b32 s45, s43, 8
s_add_u32 s45, s45, 4096
s_lshl_b32 s46, s43, 11
s_add_u32 s46, s46, 1310720
s_lshl_b32 s47, s32, 8
s_add_u32 s47, s47, s44
v_lshlrev_b32 v15, 7, v1
v_add_u32 v14, s47, v15
s_lshl_b32 s47, s32, 8
s_add_u32 s47, s47, s46
s_sub_u32 s47, s47, 256
v_add_u32 v15, s47, v15
v_cmp_lt_u32 vcc, 1, v1
s_nop 1
v_cndmask_b32 v14, v14, v15, vcc
s_add_u32 s47, s44, 2048
v_mov_b32 v15, s47
v_cmp_eq_u32 vcc, 4, v1
s_nop 1
v_cndmask_b32 v14, v14, v15, vcc
v_mov_b32 v15, s45
v_cmp_eq_u32 vcc, 5, v1
s_nop 1
v_cndmask_b32 v14, v14, v15, vcc
v_add_u32 v15, 128, v15
v_cmp_eq_u32 vcc, 6, v1
s_nop 1
v_cndmask_b32 v14, v14, v15, vcc
v_mov_b32 v16, 0xfff
s_waitcnt lgkmcnt(0)
s_load_dword s33, s[28:29], 0
s_cmp_ge_u32 s31, 16
s_cbranch_scc1 L_w_nob
s_mov_b32 exec_lo, 0xffffffff
s_mov_b32 exec_hi, 0xffffff
global_load_dwordx2 v[20:21], v26, s[16:17]
global_load_dwordx2 v[22:23], v26, s[18:19]
global_load_dwordx2 v[24:25], v26, s[20:21]
L_w_nob:
s_mov_b64 exec, 0x7f
global_load_dword v135, v14, s[28:29]
s_mov_b64 exec, -1
s_lshr_b32 s47, s31, 4
s_lshl_b32 s47, s47, 9
s_add_u32 s47, s47, 0
v_lshlrev_b32 v18, 4, v8
v_add_u32 v18, s47, v18
v_lshrrev_b32 v10, 2, v9
v_lshl_add_u32 v10, v8, 3, v10
v_lshlrev_b32 v10, 6, v10
v_and_b32 v11, 1, v8
v_xor_b32 v11, s32, v11
v_lshl_add_u32 v10, v11, 5, v10
v_and_b32 v11, 3, v1
v_lshl_add_u32 v17, v11, 3, v10
v_add_u32 v17, 4096, v17
s_lshl_b32 s47, s32, 7
s_add_u32 s47, s47, s45
v_lshlrev_b32 v19, 5, v8
v_add_u32 v19, s47, v19
v_add_u32 v27, 1830912, v19
s_waitcnt lgkmcnt(0)
s_add_u32 s33, s33, 0x1010101
s_cmp_eq_u32 s33, 0
s_cselect_b32 s33, 0x1010101, s33
s_lshr_b32 s34, s33, 8
s_lshr_b32 s35, s33, 16
s_lshr_b32 s36, s33, 24
s_lshl_b32 s37, s33, 8
s_or_b32 s36, s36, s37
s_not_b32 s37, s33
v_mov_b32 v102, s33
v_mov_b32 v103, s37
s_barrier
s_cmp_ge_u32 s32, 2
s_cbranch_scc1 L_w_noq
ds_read_b128 v[32:35], v18 offset:0
ds_read_b64_tr_b16 v[64:65], v17 offset:0
ds_read_b64_tr_b16 v[66:67], v17 offset:256
ds_read_b128 v[36:39], v18 offset:64
ds_read_b64_tr_b16 v[68:69], v17 offset:2048
ds_read_b64_tr_b16 v[70:71], v17 offset:2304
ds_read_b128 v[40:43], v18 offset:128
ds_read_b64_tr_b16 v[72:73], v17 offset:4096
ds_read_b64_tr_b16 v[74:75], v17 offset:4352
ds_read_b128 v[44:47], v18 offset:192
ds_read_b64_tr_b16 v[76:77], v17 offset:6144
ds_read_b64_tr_b16 v[78:79], v17 offset:6400
ds_read_b128 v[48:51], v18 offset:256
ds_read_b64_tr_b16 v[80:81], v17 offset:8192
ds_read_b64_tr_b16 v[82:83], v17 offset:8448
s_waitcnt lgkmcnt(12)
v_mfma_f32_16x16x32_bf16 v[96:99], v[64:67], v[32:35], 0
ds_read_b128 v[52:55], v18 offset:320
ds_read_b64_tr_b16 v[84:85], v17 offset:10240
ds_read_b64_tr_b16 v[86:87], v17 offset:10496
s_waitcnt lgkmcnt(12)
v_mfma_f32_16x16x32_bf16 v[96:99], v[68:71], v[36:39], v[96:99]
ds_read_b128 v[56:59], v18 offset:384
ds_read_b64_tr_b16 v[88:89], v17 offset:12288
ds_read_b64_tr_b16 v[90:91], v17 offset:12544
s_waitcnt lgkmcnt(12)
v_mfma_f32_16x16x32_bf16 v[96:99], v[72:75], v[40:43], v[96:99]
ds_read_b128 v[60:63], v18 offset:448
ds_read_b64_tr_b16 v[92:93], v17 offset:14336
ds_read_b64_tr_b16 v[94:95], v17 offset:14592
s_waitcnt lgkmcnt(12)
v_mfma_f32_16x16x32_bf16 v[96:99], v[76:79], v[44:47], v[96:99]
s_waitcnt lgkmcnt(9)
v_mfma_f32_16x16x32_bf16 v[96:99], v[80:83], v[48:51], v[96:99]
s_waitcnt lgkmcnt(6)
v_mfma_f32_16x16x32_bf16 v[96:99], v[84:87], v[52:55], v[96:99]
s_waitcnt lgkmcnt(3)
v_mfma_f32_16x16x32_bf16 v[96:99], v[88:91], v[56:59], v[96:99]
s_waitcnt lgkmcnt(0)
v_mfma_f32_16x16x32_bf16 v[96:99], v[92:95], v[60:63], v[96:99]
s_lshl_b32 s47, s32, 2
s_add_u32 s47, s47, 2160
v_mov_b32 v10, s47
v_mov_b32 v11, 1
s_nop 3
v_mov_b64 v[100:101], v[98:99]
v_mov_b64 v[98:99], v[102:103]
s_mov_b32 exec_lo, 0x10001
s_mov_b32 exec_hi, 0x10001
global_store_dwordx4 v19, v[96:99], s[28:29]
global_store_dwordx4 v19, v[100:103], s[28:29] offset:16
global_store_dwordx4 v27, v[96:99], s[28:29] sc1
global_store_dwordx4 v27, v[100:103], s[28:29] offset:16 sc1
ds_write_b32 v10, v11
s_mov_b64 exec, -1
L_w_noq:
s_cmp_ge_u32 s31, 16
s_cbranch_scc1 L_w_nob2
v_mov_b32 v10, 3840
s_mov_b32 s50, 0
L_w_hs:
ds_read_b128 v[28:31], v10
s_add_u32 s50, s50, 1
s_cmp_gt_u32 s50, 0x400000
s_cbranch_scc1 L_w_hsx
s_waitcnt lgkmcnt(0)
v_max3_u32 v11, v28, v29, v30
v_max_u32 v11, v11, v31
v_cmp_eq_u32 vcc, -1, v11
s_cbranch_vccnz L_w_hs
L_w_hsx:
s_cmp_ge_u32 s32, 2
s_cbranch_scc1 L_w_bw1
s_waitcnt vmcnt(5)
s_branch L_w_bw2
L_w_bw1:
s_waitcnt vmcnt(1)
L_w_bw2:
v_lshlrev_b32 v100, 16, v20
v_and_b32 v101, 0xffff0000, v20
v_lshlrev_b32 v104, 16, v22
v_and_b32 v105, 0xffff0000, v22
v_lshlrev_b32 v102, 16, v21
v_and_b32 v103, 0xffff0000, v21
v_lshlrev_b32 v106, 16, v23
v_and_b32 v107, 0xffff0000, v23
v_mov_b32 v108, 0xc0135761
v_mov_b32 v109, 0xbdd2d3e8
v_mov_b32 v110, 1.0
v_mov_b32 v111, 1.0
s_waitcnt lgkmcnt(0)
v_pk_mul_f32 v[116:117], v[100:101], v[28:29] op_sel_hi:[1,0]
v_cvt_pk_bf16_f32 v118, v116, v117
v_lshlrev_b32 v116, 16, v118
v_and_b32 v117, 0xffff0000, v118
v_pk_add_f32 v[116:117], v[116:117], v[104:105]
v_cvt_pk_bf16_f32 v118, v116, v117
v_lshlrev_b32 v116, 16, v118
v_and_b32 v117, 0xffff0000, v118
v_pk_mul_f32 v[118:119], v[116:117], v[116:117]
v_pk_fma_f32 v[118:119], v[118:119], v[108:109], v[108:109] op_sel:[0,1,0] op_sel_hi:[1,1,0]
v_pk_mul_f32 v[118:119], v[118:119], v[116:117]
v_exp_f32 v118, v118
v_exp_f32 v119, v119
s_nop 0
v_pk_add_f32 v[118:119], v[118:119], v[110:111]
v_rcp_f32 v118, v118
v_rcp_f32 v119, v119
s_nop 0
v_pk_mul_f32 v[118:119], v[118:119], v[116:117]
v_cvt_pk_bf16_f32 v120, v118, v119
v_dot2_f32_bf16 v112, v120, v24, 0
v_pk_mul_f32 v[124:125], v[102:103], v[28:29] op_sel_hi:[1,0]
v_cvt_pk_bf16_f32 v126, v124, v125
v_lshlrev_b32 v124, 16, v126
v_and_b32 v125, 0xffff0000, v126
v_pk_add_f32 v[124:125], v[124:125], v[106:107]
v_cvt_pk_bf16_f32 v126, v124, v125
v_lshlrev_b32 v124, 16, v126
v_and_b32 v125, 0xffff0000, v126
v_pk_mul_f32 v[126:127], v[124:125], v[124:125]
v_pk_fma_f32 v[126:127], v[126:127], v[108:109], v[108:109] op_sel:[0,1,0] op_sel_hi:[1,1,0]
v_pk_mul_f32 v[126:127], v[126:127], v[124:125]
v_exp_f32 v126, v126
v_exp_f32 v127, v127
s_nop 0
v_pk_add_f32 v[126:127], v[126:127], v[110:111]
v_rcp_f32 v126, v126
v_rcp_f32 v127, v127
s_nop 0
v_pk_mul_f32 v[126:127], v[126:127], v[124:125]
v_cvt_pk_bf16_f32 v128, v126, v127
v_dot2_f32_bf16 v112, v128, v25, v112
v_pk_mul_f32 v[116:117], v[100:101], v[28:29] op_sel:[0,1] op_sel_hi:[1,1]
v_cvt_pk_bf16_f32 v118, v116, v117
v_lshlrev_b32 v116, 16, v118
v_and_b32 v117, 0xffff0000, v118
v_pk_add_f32 v[116:117], v[116:117], v[104:105]
v_cvt_pk_bf16_f32 v118, v116, v117
v_lshlrev_b32 v116, 16, v118
v_and_b32 v117, 0xffff0000, v118
v_pk_mul_f32 v[118:119], v[116:117], v[116:117]
v_pk_fma_f32 v[118:119], v[118:119], v[108:109], v[108:109] op_sel:[0,1,0] op_sel_hi:[1,1,0]
v_pk_mul_f32 v[118:119], v[118:119], v[116:117]
v_exp_f32 v118, v118
v_exp_f32 v119, v119
s_nop 0
v_pk_add_f32 v[118:119], v[118:119], v[110:111]
v_rcp_f32 v118, v118
v_rcp_f32 v119, v119
s_nop 0
v_pk_mul_f32 v[118:119], v[118:119], v[116:117]
v_cvt_pk_bf16_f32 v120, v118, v119
v_dot2_f32_bf16 v113, v120, v24, 0
v_pk_mul_f32 v[124:125], v[102:103], v[28:29] op_sel:[0,1] op_sel_hi:[1,1]
v_cvt_pk_bf16_f32 v126, v124, v125
v_lshlrev_b32 v124, 16, v126
v_and_b32 v125, 0xffff0000, v126
v_pk_add_f32 v[124:125], v[124:125], v[106:107]
v_cvt_pk_bf16_f32 v126, v124, v125
v_lshlrev_b32 v124, 16, v126
v_and_b32 v125, 0xffff0000, v126
v_pk_mul_f32 v[126:127], v[124:125], v[124:125]
v_pk_fma_f32 v[126:127], v[126:127], v[108:109], v[108:109] op_sel:[0,1,0] op_sel_hi:[1,1,0]
v_pk_mul_f32 v[126:127], v[126:127], v[124:125]
v_exp_f32 v126, v126
v_exp_f32 v127, v127
s_nop 0
v_pk_add_f32 v[126:127], v[126:127], v[110:111]
v_rcp_f32 v126, v126
v_rcp_f32 v127, v127
s_nop 0
v_pk_mul_f32 v[126:127], v[126:127], v[124:125]
v_cvt_pk_bf16_f32 v128, v126, v127
v_dot2_f32_bf16 v113, v128, v25, v113
v_pk_mul_f32 v[116:117], v[100:101], v[30:31] op_sel_hi:[1,0]
v_cvt_pk_bf16_f32 v118, v116, v117
v_lshlrev_b32 v116, 16, v118
v_and_b32 v117, 0xffff0000, v118
v_pk_add_f32 v[116:117], v[116:117], v[104:105]
v_cvt_pk_bf16_f32 v118, v116, v117
v_lshlrev_b32 v116, 16, v118
v_and_b32 v117, 0xffff0000, v118
v_pk_mul_f32 v[118:119], v[116:117], v[116:117]
v_pk_fma_f32 v[118:119], v[118:119], v[108:109], v[108:109] op_sel:[0,1,0] op_sel_hi:[1,1,0]
v_pk_mul_f32 v[118:119], v[118:119], v[116:117]
v_exp_f32 v118, v118
v_exp_f32 v119, v119
s_nop 0
v_pk_add_f32 v[118:119], v[118:119], v[110:111]
v_rcp_f32 v118, v118
v_rcp_f32 v119, v119
s_nop 0
v_pk_mul_f32 v[118:119], v[118:119], v[116:117]
v_cvt_pk_bf16_f32 v120, v118, v119
v_dot2_f32_bf16 v114, v120, v24, 0
v_pk_mul_f32 v[124:125], v[102:103], v[30:31] op_sel_hi:[1,0]
v_cvt_pk_bf16_f32 v126, v124, v125
v_lshlrev_b32 v124, 16, v126
v_and_b32 v125, 0xffff0000, v126
v_pk_add_f32 v[124:125], v[124:125], v[106:107]
v_cvt_pk_bf16_f32 v126, v124, v125
v_lshlrev_b32 v124, 16, v126
v_and_b32 v125, 0xffff0000, v126
v_pk_mul_f32 v[126:127], v[124:125], v[124:125]
v_pk_fma_f32 v[126:127], v[126:127], v[108:109], v[108:109] op_sel:[0,1,0] op_sel_hi:[1,1,0]
v_pk_mul_f32 v[126:127], v[126:127], v[124:125]
v_exp_f32 v126, v126
v_exp_f32 v127, v127
s_nop 0
v_pk_add_f32 v[126:127], v[126:127], v[110:111]
v_rcp_f32 v126, v126
v_rcp_f32 v127, v127
s_nop 0
v_pk_mul_f32 v[126:127], v[126:127], v[124:125]
v_cvt_pk_bf16_f32 v128, v126, v127
v_dot2_f32_bf16 v114, v128, v25, v114
v_pk_mul_f32 v[116:117], v[100:101], v[30:31] op_sel:[0,1] op_sel_hi:[1,1]
v_cvt_pk_bf16_f32 v118, v116, v117
v_lshlrev_b32 v116, 16, v118
v_and_b32 v117, 0xffff0000, v118
v_pk_add_f32 v[116:117], v[116:117], v[104:105]
v_cvt_pk_bf16_f32 v118, v116, v117
v_lshlrev_b32 v116, 16, v118
v_and_b32 v117, 0xffff0000, v118
v_pk_mul_f32 v[118:119], v[116:117], v[116:117]
v_pk_fma_f32 v[118:119], v[118:119], v[108:109], v[108:109] op_sel:[0,1,0] op_sel_hi:[1,1,0]
v_pk_mul_f32 v[118:119], v[118:119], v[116:117]
v_exp_f32 v118, v118
v_exp_f32 v119, v119
s_nop 0
v_pk_add_f32 v[118:119], v[118:119], v[110:111]
v_rcp_f32 v118, v118
v_rcp_f32 v119, v119
s_nop 0
v_pk_mul_f32 v[118:119], v[118:119], v[116:117]
v_cvt_pk_bf16_f32 v120, v118, v119
v_dot2_f32_bf16 v115, v120, v24, 0
v_pk_mul_f32 v[124:125], v[102:103], v[30:31] op_sel:[0,1] op_sel_hi:[1,1]
v_cvt_pk_bf16_f32 v126, v124, v125
v_lshlrev_b32 v124, 16, v126
v_and_b32 v125, 0xffff0000, v126
v_pk_add_f32 v[124:125], v[124:125], v[106:107]
v_cvt_pk_bf16_f32 v126, v124, v125
v_lshlrev_b32 v124, 16, v126
v_and_b32 v125, 0xffff0000, v126
v_pk_mul_f32 v[126:127], v[124:125], v[124:125]
v_pk_fma_f32 v[126:127], v[126:127], v[108:109], v[108:109] op_sel:[0,1,0] op_sel_hi:[1,1,0]
v_pk_mul_f32 v[126:127], v[126:127], v[124:125]
v_exp_f32 v126, v126
v_exp_f32 v127, v127
s_nop 0
v_pk_add_f32 v[126:127], v[126:127], v[110:111]
v_rcp_f32 v126, v126
v_rcp_f32 v127, v127
s_nop 0
v_pk_mul_f32 v[126:127], v[126:127], v[124:125]
v_cvt_pk_bf16_f32 v128, v126, v127
v_dot2_f32_bf16 v115, v128, v25, v115
v_add_f32_dpp v112, v112, v112 row_shr:1 row_mask:0xf bank_mask:0xf bound_ctrl:0
v_add_f32_dpp v113, v113, v113 row_shr:1 row_mask:0xf bank_mask:0xf bound_ctrl:0
v_add_f32_dpp v114, v114, v114 row_shr:1 row_mask:0xf bank_mask:0xf bound_ctrl:0
v_add_f32_dpp v115, v115, v115 row_shr:1 row_mask:0xf bank_mask:0xf bound_ctrl:0
v_add_f32_dpp v112, v112, v112 row_shr:2 row_mask:0xf bank_mask:0xf bound_ctrl:0
v_add_f32_dpp v113, v113, v113 row_shr:2 row_mask:0xf bank_mask:0xf bound_ctrl:0
v_add_f32_dpp v114, v114, v114 row_shr:2 row_mask:0xf bank_mask:0xf bound_ctrl:0
v_add_f32_dpp v115, v115, v115 row_shr:2 row_mask:0xf bank_mask:0xf bound_ctrl:0
v_add_f32_dpp v112, v112, v112 row_shr:4 row_mask:0xf bank_mask:0xf bound_ctrl:0
v_add_f32_dpp v113, v113, v113 row_shr:4 row_mask:0xf bank_mask:0xf bound_ctrl:0
v_add_f32_dpp v114, v114, v114 row_shr:4 row_mask:0xf bank_mask:0xf bound_ctrl:0
v_add_f32_dpp v115, v115, v115 row_shr:4 row_mask:0xf bank_mask:0xf bound_ctrl:0
v_add_f32_dpp v112, v112, v112 row_shr:8 row_mask:0xf bank_mask:0xf bound_ctrl:0
v_add_f32_dpp v113, v113, v113 row_shr:8 row_mask:0xf bank_mask:0xf bound_ctrl:0
v_add_f32_dpp v114, v114, v114 row_shr:8 row_mask:0xf bank_mask:0xf bound_ctrl:0
v_add_f32_dpp v115, v115, v115 row_shr:8 row_mask:0xf bank_mask:0xf bound_ctrl:0
v_add_f32_dpp v112, v112, v112 row_bcast:15 row_mask:0xa bank_mask:0xf
v_add_f32_dpp v113, v113, v113 row_bcast:15 row_mask:0xa bank_mask:0xf
v_add_f32_dpp v114, v114, v114 row_bcast:15 row_mask:0xa bank_mask:0xf
v_add_f32_dpp v115, v115, v115 row_bcast:15 row_mask:0xa bank_mask:0xf
v_add_f32_dpp v112, v112, v112 row_bcast:31 row_mask:0xc bank_mask:0xf
v_add_f32_dpp v113, v113, v113 row_bcast:31 row_mask:0xc bank_mask:0xf
v_add_f32_dpp v114, v114, v114 row_bcast:31 row_mask:0xc bank_mask:0xf
v_add_f32_dpp v115, v115, v115 row_bcast:31 row_mask:0xc bank_mask:0xf
s_lshl_b32 s47, s32, 4
s_add_u32 s47, s47, 2192
v_mov_b32 v10, s47
s_mov_b32 exec_lo, 0x0
s_mov_b32 exec_hi, 0x80000000
ds_write_b128 v10, v[112:115]
s_mov_b64 exec, -1
L_w_nob2:
v_lshrrev_b32 v10, 2, v9
v_lshl_add_u32 v11, v8, 2, v10
v_lshlrev_b32 v32, 8, v11
v_lshlrev_b32 v10, 1, v10
v_and_b32 v33, 1, v8
v_lshl_add_u32 v10, v33, 3, v10
v_bfe_u32 v33, v1, 1, 1
s_lshl_b32 s47, s32, 1
v_add_u32 v34, s47, v33
v_xor_b32 v10, v10, v34
v_lshl_add_u32 v32, v10, 4, v32
v_and_b32 v34, 1, v1
v_lshl_add_u32 v32, v34, 3, v32
v_add_u32 v80, 53248, v32
s_lshl_b32 s47, s32, 8
s_add_u32 s47, s47, s44
v_lshlrev_b32 v32, 6, v9
v_lshl_add_u32 v32, v8, 4, v32
v_add_u32 v81, s47, v32
v_add_u32 v82, 589824, v81
s_lshl_b32 s47, s32, 8
s_add_u32 s47, s47, s46
v_add_u32 v91, s47, v32
v_lshrrev_b32 v10, 1, v11
v_and_b32 v10, 3, v10
v_lshlrev_b32 v10, 1, v10
v_xor_b32 v10, v10, v33
v_lshlrev_b32 v10, 4, v10
v_lshl_add_u32 v11, v11, 7, v10
v_lshl_add_u32 v11, v34, 3, v11
s_add_u32 s47, s41, 86016
v_add_u32 v83, s47, v11
v_xor_b32 v84, 32, v83
v_xor_b32 v85, 64, v83
v_xor_b32 v86, 96, v83
v_lshlrev_b32 v10, 3, v8
v_add_u32 v10, 2112, v10
v_mov_b32 v11, 2176
v_cmp_eq_u32 vcc, 0, v9
s_nop 1
v_cndmask_b32 v87, v11, v10, vcc
v_cmp_eq_u32 vcc, 1, v9
s_nop 1
v_cndmask_b32 v88, v11, v10, vcc
v_cmp_eq_u32 vcc, 2, v9
s_nop 1
v_cndmask_b32 v89, v11, v10, vcc
v_cmp_eq_u32 vcc, 3, v9
s_nop 1
v_cndmask_b32 v90, v11, v10, vcc
v_xor_b32 v10, v8, v9
v_lshlrev_b32 v10, 4, v10
v_lshl_add_u32 v10, v9, 8, v10
s_add_u32 s47, s42, 20480
v_add_u32 v28, s47, v10
v_xor_b32 v29, 64, v28
v_xor_b32 v30, 128, v28
v_xor_b32 v31, 192, v28
v_and_b32 v11, 3, v9
v_mul_u32_u24 v10, 272, v11
v_lshl_add_u32 v10, v8, 4, v10
v_add_u32 v17, 1024, v10
v_lshlrev_b32 v18, 5, v11
s_lshl_b32 s47, s32, 2
v_add_u32 v19, s47, v18
v_lshl_add_u32 v14, v8, 2, v11
v_lshlrev_b32 v14, 4, v14
s_lshr_b32 s47, s32, 1
s_lshl_b32 s47, s47, 8
s_and_b32 s50, s32, 1
s_lshl_b32 s50, s50, 3
s_add_u32 s47, s47, s50
v_add_u32 v15, s47, v14
v_mov_b32 v13, 0x3db504f3
v_mov_b32 v12, 2160
s_mov_b32 s50, 0
L_w_sk:
ds_read_b32 v10, v12 offset:12
s_add_u32 s50, s50, 1
s_cmp_gt_u32 s50, 0x400000
s_cbranch_scc1 L_w_skx
s_waitcnt lgkmcnt(0)
v_cmp_ne_u32 vcc, 1, v10
s_cbranch_vccnz L_w_sk
L_w_skx:
ds_read_b128 v[32:35], v28
ds_read_b128 v[36:39], v29
ds_read_b128 v[40:43], v30
ds_read_b128 v[44:47], v31
L_w_s2:
ds_read_b32 v10, v12 offset:8
s_add_u32 s50, s50, 1
s_cmp_gt_u32 s50, 0x400000
s_cbranch_scc1 L_w_s2x
s_waitcnt lgkmcnt(0)
v_cmp_ne_u32 vcc, 1, v10
s_cbranch_vccnz L_w_s2
L_w_s2x:
ds_read_b128 v[48:51], v17 offset:0
ds_read_b128 v[52:55], v17 offset:64
ds_read_b128 v[56:59], v17 offset:128
ds_read_b128 v[60:63], v17 offset:192
s_waitcnt lgkmcnt(3)
v_mfma_f32_16x16x32_bf16 v[64:67], v[32:35], v[48:51], 0
s_waitcnt lgkmcnt(2)
v_mfma_f32_16x16x32_bf16 v[64:67], v[36:39], v[52:55], v[64:67]
s_waitcnt lgkmcnt(1)
v_mfma_f32_16x16x32_bf16 v[64:67], v[40:43], v[56:59], v[64:67]
s_waitcnt lgkmcnt(0)
v_mfma_f32_16x16x32_bf16 v[64:67], v[44:47], v[60:63], v[64:67]
s_nop 7
v_cvt_pk_bf16_f32 v68, v64, v65
v_cvt_pk_bf16_f32 v69, v66, v67
v_lshlrev_b32 v64, 16, v68
v_and_b32 v65, 0xffff0000, v68
v_lshlrev_b32 v66, 16, v69
v_and_b32 v67, 0xffff0000, v69
v_pk_mul_f32 v[64:65], v[64:65], v[12:13] op_sel:[0,1] op_sel_hi:[1,1]
v_pk_mul_f32 v[66:67], v[66:67], v[12:13] op_sel:[0,1] op_sel_hi:[1,1]
v_cvt_pk_bf16_f32 v68, v64, v65
v_cvt_pk_bf16_f32 v69, v66, v67
v_lshlrev_b32 v64, 16, v68
v_and_b32 v65, 0xffff0000, v68
v_lshlrev_b32 v66, 16, v69
v_and_b32 v67, 0xffff0000, v69
v_max3_f32 v70, v64, v65, v66
v_max_f32 v70, v70, v67
v_mov_b32 v71, v70
s_nop 1
v_permlane16_swap_b32 v70, v71
v_max_f32 v70, v70, v71
v_mov_b32 v71, v70
s_nop 1
v_permlane32_swap_b32 v70, v71
v_max_f32 v70, v70, v71
s_mov_b64 exec, 0xf
ds_write_b32 v19, v70 offset:3584
s_mov_b64 exec, -1
v_mov_b32 v13, 0x3fb8aa3b
s_mov_b32 s50, 0
L_w_s3:
ds_read_b128 v[72:75], v18 offset:3584
ds_read_b128 v[76:79], v18 offset:3600
s_add_u32 s50, s50, 1
s_cmp_gt_u32 s50, 0x400000
s_cbranch_scc1 L_w_s3x
s_waitcnt lgkmcnt(0)
v_max3_u32 v71, v72, v73, v74
v_max3_u32 v71, v71, v75, v76
v_max3_u32 v71, v71, v77, v78
v_max_u32 v71, v71, v79
v_cmp_eq_u32 vcc, -1, v71
s_cbranch_vccnz L_w_s3
L_w_s3x:
v_max3_f32 v70, v72, v73, v74
v_max3_f32 v70, v70, v75, v76
v_max3_f32 v70, v70, v77, v78
v_max_f32 v70, v70, v79
v_sub_f32 v64, v64, v70
v_sub_f32 v65, v65, v70
v_sub_f32 v66, v66, v70
v_sub_f32 v67, v67, v70
v_mul_f32 v64, v13, v64
v_mul_f32 v65, v13, v65
v_mul_f32 v66, v13, v66
v_mul_f32 v67, v13, v67
v_exp_f32 v64, v64
v_exp_f32 v65, v65
v_exp_f32 v66, v66
v_exp_f32 v67, v67
v_cvt_pk_bf16_f32 v72, v64, v65
v_cvt_pk_bf16_f32 v73, v66, v67
v_add_f32 v74, v64, v65
v_add_f32 v75, v66, v67
v_add_f32 v74, v74, v75
s_mov_b32 exec_lo, 0xf000f
s_mov_b32 exec_hi, 0xf000f
ds_write_b64 v15, v[72:73] offset:2560
s_mov_b64 exec, -1
v_mov_b32 v75, v74
s_nop 1
v_permlane16_swap_b32 v74, v75
v_add_f32 v74, v74, v75
v_mov_b32 v75, v74
s_nop 1
v_permlane32_swap_b32 v74, v75
v_add_f32 v74, v74, v75
s_mov_b64 exec, 0xf
ds_write_b32 v19, v74 offset:3712
s_mov_b64 exec, -1
s_waitcnt lgkmcnt(0)
s_barrier
ds_read_b128 v[32:35], v14 offset:2560
ds_read_b64_tr_b16 v[48:49], v80 offset:0
ds_read_b64_tr_b16 v[50:51], v80 offset:4096
ds_read_b128 v[36:39], v14 offset:2816
ds_read_b64_tr_b16 v[52:53], v80 offset:8192
ds_read_b64_tr_b16 v[54:55], v80 offset:12288
ds_read_b128 v[40:43], v14 offset:3072
ds_read_b64_tr_b16 v[56:57], v80 offset:16384
ds_read_b64_tr_b16 v[58:59], v80 offset:20480
ds_read_b128 v[44:47], v14 offset:3328
ds_read_b64_tr_b16 v[60:61], v80 offset:24576
ds_read_b64_tr_b16 v[62:63], v80 offset:28672
s_waitcnt lgkmcnt(9)
v_mfma_f32_16x16x32_bf16 v[64:67], v[48:51], v[32:35], 0
s_waitcnt lgkmcnt(6)
v_mfma_f32_16x16x32_bf16 v[64:67], v[52:55], v[36:39], v[64:67]
s_waitcnt lgkmcnt(3)
v_mfma_f32_16x16x32_bf16 v[64:67], v[56:59], v[40:43], v[64:67]
s_waitcnt lgkmcnt(0)
v_mfma_f32_16x16x32_bf16 v[64:67], v[60:63], v[44:47], v[64:67]
s_nop 7
v_bfi_b32 v64, v16, s33, v64
v_bfi_b32 v65, v16, s34, v65
v_bfi_b32 v66, v16, s35, v66
v_bfi_b32 v67, v16, s36, v67
s_mov_b32 exec_lo, 0xf000f
s_mov_b32 exec_hi, 0xf000f
global_store_dwordx4 v81, v[64:67], s[28:29]
global_store_dwordx4 v82, v[64:67], s[28:29] sc1
s_mov_b64 exec, -1
v_mov_b32 v10, 2188
s_mov_b32 s50, 0
L_w_wf:
ds_read_b32 v11, v10
s_add_u32 s50, s50, 1
s_cmp_gt_u32 s50, 0x400000
s_cbranch_scc1 L_w_wfx
s_waitcnt lgkmcnt(0)
v_cmp_ne_u32 vcc, 1, v11
s_cbranch_vccnz L_w_wf
L_w_wfx:
ds_read_b64_tr_b16 v[32:33], v83
ds_read_b64_tr_b16 v[34:35], v84
ds_read_b64_tr_b16 v[36:37], v85
ds_read_b64_tr_b16 v[38:39], v86
s_waitcnt lgkmcnt(0)
s_barrier
ds_read_b64 v[40:41], v87
ds_read_b64 v[42:43], v88
ds_read_b64 v[44:45], v89
ds_read_b64 v[46:47], v90
s_waitcnt lgkmcnt(3)
v_mfma_f32_16x16x16_bf16 v[64:67], v[32:33], v[40:41], 0
s_waitcnt lgkmcnt(2)
v_mfma_f32_16x16x16_bf16 v[64:67], v[34:35], v[42:43], v[64:67]
s_waitcnt lgkmcnt(1)
v_mfma_f32_16x16x16_bf16 v[64:67], v[36:37], v[44:45], v[64:67]
s_waitcnt lgkmcnt(0)
v_mfma_f32_16x16x16_bf16 v[64:67], v[38:39], v[46:47], v[64:67]
s_nop 7
v_bfi_b32 v64, v16, s33, v64
v_bfi_b32 v65, v16, s34, v65
v_bfi_b32 v66, v16, s35, v66
v_bfi_b32 v67, v16, s36, v67
s_mov_b32 exec_lo, 0xf000f
s_mov_b32 exec_hi, 0xf000f
global_store_dwordx4 v91, v[64:67], s[28:29] sc1
s_waitcnt vmcnt(0)
v_mov_b32 v10, 2184
v_mov_b32 v11, 1
s_mov_b64 exec, 1
ds_add_u32 v10, v11
s_mov_b64 exec, -1
s_branch L_end
L_comm:
v_lshrrev_b32 v8, 4, v1
v_and_b32 v9, 15, v1
s_mov_b32 s48, 0x05040100
s_load_dword s33, s[28:29], 0
s_load_dword s39, s[22:23], 0
v_mov_b32 v16, -1
v_mov_b32 v17, -1
v_mov_b32 v18, -1
v_mov_b32 v19, -1
v_add_u32 v10, 2560, v3
ds_write_b128 v10, v[16:19]
s_mov_b64 exec, 0x1ffff
ds_write_b128 v10, v[16:19] offset:1024
v_mov_b32 v16, 0
v_mov_b32 v17, 0
v_mov_b32 v18, 0
v_mov_b32 v19, 0
s_mov_b64 exec, 3
ds_write_b128 v3, v[16:19] offset:2160
s_mov_b64 exec, -1
s_lshl_b32 s51, s30, 4
s_add_u32 s51, s51, s31
s_mov_b32 s50, 0
s_waitcnt vmcnt(8)
v_mov_b32 v24, v12
v_mov_b32 v25, v13
v_mov_b32 v26, v14
v_mov_b32 v27, v15
L_c_ln:
v_lshlrev_b32 v32, 16, v24
v_and_b32 v33, 0xffff0000, v24
v_lshlrev_b32 v34, 16, v25
v_and_b32 v35, 0xffff0000, v25
v_lshlrev_b32 v36, 16, v26
v_and_b32 v37, 0xffff0000, v26
v_lshlrev_b32 v38, 16, v27
v_and_b32 v39, 0xffff0000, v27
v_pk_add_f32 v[40:41], v[32:33], v[34:35]
v_pk_add_f32 v[42:43], v[36:37], v[38:39]
v_pk_add_f32 v[40:41], v[40:41], v[42:43]
v_add_f32 v40, v40, v41
s_nop 1
v_add_f32_dpp v40, v40, v40 row_shr:1 row_mask:0xf bank_mask:0xf bound_ctrl:0
s_nop 1
v_add_f32_dpp v40, v40, v40 row_shr:2 row_mask:0xf bank_mask:0xf bound_ctrl:0
s_nop 1
v_add_f32_dpp v40, v40, v40 row_shr:4 row_mask:0xf bank_mask:0xf bound_ctrl:0
s_nop 1
v_add_f32_dpp v40, v40, v40 row_shr:8 row_mask:0xf bank_mask:0xf bound_ctrl:0
s_nop 1
v_add_f32_dpp v40, v40, v40 row_bcast:15 row_mask:0xa bank_mask:0xf
s_nop 1
v_add_f32_dpp v40, v40, v40 row_bcast:31 row_mask:0xc bank_mask:0xf
s_nop 0
v_readlane_b32 s40, v40, 63
s_nop 1
v_mov_b32 v40, s40
v_mul_f32 v40, 0x3b000000, v40
v_sub_f32 v42, v32, v40
v_mul_f32 v41, v42, v42
v_sub_f32 v42, v33, v40
v_fmac_f32 v41, v42, v42
v_sub_f32 v42, v34, v40
v_fmac_f32 v41, v42, v42
v_sub_f32 v42, v35, v40
v_fmac_f32 v41, v42, v42
v_sub_f32 v42, v36, v40
v_fmac_f32 v41, v42, v42
v_sub_f32 v42, v37, v40
v_fmac_f32 v41, v42, v42
v_sub_f32 v42, v38, v40
v_fmac_f32 v41, v42, v42
v_sub_f32 v42, v39, v40
v_fmac_f32 v41, v42, v42
s_nop 1
v_add_f32_dpp v41, v41, v41 row_shr:1 row_mask:0xf bank_mask:0xf bound_ctrl:0
s_nop 1
v_add_f32_dpp v41, v41, v41 row_shr:2 row_mask:0xf bank_mask:0xf bound_ctrl:0
s_nop 1
v_add_f32_dpp v41, v41, v41 row_shr:4 row_mask:0xf bank_mask:0xf bound_ctrl:0
s_nop 1
v_add_f32_dpp v41, v41, v41 row_shr:8 row_mask:0xf bank_mask:0xf bound_ctrl:0
s_nop 1
v_add_f32_dpp v41, v41, v41 row_bcast:15 row_mask:0xa bank_mask:0xf
s_nop 1
v_add_f32_dpp v41, v41, v41 row_bcast:31 row_mask:0xc bank_mask:0xf
s_nop 0
v_readlane_b32 s41, v41, 63
v_cvt_pk_bf16_f32 v40, v40, v40
v_and_b32 v40, 0xffff0000, v40
v_mov_b32 v41, s41
v_mul_f32 v41, 0x3b000000, v41
v_cvt_pk_bf16_f32 v41, v41, v41
v_and_b32 v41, 0xffff0000, v41
v_add_f32 v41, 0x3727c5ac, v41
v_cvt_pk_bf16_f32 v41, v41, v41
v_and_b32 v41, 0xffff0000, v41
v_sqrt_f32 v41, v41
s_nop 0
v_cvt_pk_bf16_f32 v41, v41, v41
v_and_b32 v41, 0xffff0000, v41
v_rcp_f32 v42, v41
v_sub_f32 v40, 0, v40
v_pk_add_f32 v[32:33], v[32:33], v[40:41] op_sel_hi:[1,0]
v_pk_add_f32 v[34:35], v[34:35], v[40:41] op_sel_hi:[1,0]
v_pk_add_f32 v[36:37], v[36:37], v[40:41] op_sel_hi:[1,0]
v_pk_add_f32 v[38:39], v[38:39], v[40:41] op_sel_hi:[1,0]
v_cvt_pk_bf16_f32 v43, v32, v33
v_lshlrev_b32 v32, 16, v43
v_and_b32 v33, 0xffff0000, v43
v_cvt_pk_bf16_f32 v43, v34, v35
v_lshlrev_b32 v34, 16, v43
v_and_b32 v35, 0xffff0000, v43
v_cvt_pk_bf16_f32 v43, v36, v37
v_lshlrev_b32 v36, 16, v43
v_and_b32 v37, 0xffff0000, v43
v_cvt_pk_bf16_f32 v43, v38, v39
v_lshlrev_b32 v38, 16, v43
v_and_b32 v39, 0xffff0000, v43
v_pk_mul_f32 v[32:33], v[32:33], v[42:43] op_sel_hi:[1,0]
v_pk_mul_f32 v[34:35], v[34:35], v[42:43] op_sel_hi:[1,0]
v_pk_mul_f32 v[36:37], v[36:37], v[42:43] op_sel_hi:[1,0]
v_pk_mul_f32 v[38:39], v[38:39], v[42:43] op_sel_hi:[1,0]
v_cvt_pk_bf16_f32 v24, v32, v33
v_cvt_pk_bf16_f32 v25, v34, v35
v_cvt_pk_bf16_f32 v26, v36, v37
v_cvt_pk_bf16_f32 v27, v38, v39
s_cmp_lg_u32 s50, 0
s_cbranch_scc1 L_c_ln2
v_add_u32 v10, 0, v3
ds_write_b128 v10, v[24:27]
s_waitcnt vmcnt(0) lgkmcnt(0)
s_add_u32 s33, s33, 0x1010101
s_cmp_eq_u32 s33, 0
s_cselect_b32 s33, 0x1010101, s33
s_lshr_b32 s34, s33, 8
s_lshr_b32 s35, s33, 16
s_lshr_b32 s36, s33, 24
s_lshl_b32 s37, s33, 8
s_or_b32 s36, s36, s37
s_and_b32 s94, s33, 0xfff
s_and_b32 s37, s34, 0xfff
s_lshl_b32 s37, s37, 16
s_or_b32 s94, s94, s37
s_and_b32 s95, s35, 0xfff
s_and_b32 s37, s36, 0xfff
s_lshl_b32 s37, s37, 16
s_or_b32 s95, s95, s37
v_mov_b32 v130, 0xfff0fff
s_and_b32 s92, s94, 0xff00ff
s_and_b32 s93, s95, 0xff00ff
v_mov_b32 v131, 0xff00ff
s_barrier
s_mov_b32 s50, 1
s_cmp_ge_u32 s31, 16
s_cbranch_scc0 L_c_ln
s_branch L_c_noln2
L_c_ln2:
s_lshr_b32 s40, s51, 1
s_and_b32 s41, s51, 1
s_cmp_eq_u32 s41, 1
s_cselect_b64 vcc, -1, 0
v_cndmask_b32 v28, v24, v26, vcc
v_cndmask_b32 v29, v25, v27, vcc
v_cndmask_b32 v30, v12, v14, vcc
v_cndmask_b32 v31, v13, v15, vcc
v_readlane_b32 s54, v28, s40
v_readlane_b32 s55, v29, s40
v_readlane_b32 s56, v30, s40
v_readlane_b32 s57, v31, s40
s_lshl_b32 s58, s54, 16
s_and_b32 s54, s54, 0xffff0000
s_lshl_b32 s59, s55, 16
s_and_b32 s55, s55, 0xffff0000
v_mov_b32 v28, s58
v_mov_b32 v29, s54
v_mov_b32 v30, s59
v_mov_b32 v31, s55
v_mov_b32 v10, 3840
s_mov_b64 exec, 1
ds_write_b128 v10, v[28:31]
s_mov_b64 exec, -1
L_c_noln2:
s_lshl_b32 s40, s30, 13
s_add_u32 s40, s40, 4096
s_add_u32 s52, s28, s40
s_addc_u32 s53, s29, 0
v_mov_b32 v10, 2160
v_add_u32 v128, 4096, v3
v_lshlrev_b32 v129, 2, v1
s_not_b32 s92, s33
s_mov_b32 s50, 0
L_c_qf:
ds_read_b64 v[32:33], v10
s_add_u32 s50, s50, 1
s_cmp_gt_u32 s50, 0x400000
s_cbranch_scc1 L_c_qf2
s_waitcnt lgkmcnt(0)
v_and_b32 v32, v32, v33
v_cmp_ne_u32 vcc, 1, v32
s_cbranch_vccnz L_c_qf
L_c_qf2:
v_mov_b32 v11, 1
s_mov_b32 s50, 0
global_load_dwordx4 v[32:35], v3, s[52:53] sc1
global_load_dwordx4 v[36:39], v3, s[52:53] offset:1024 sc1
global_load_dwordx4 v[40:43], v3, s[52:53] offset:2048 sc1
global_load_dwordx4 v[44:47], v3, s[52:53] offset:3072 sc1
global_load_dwordx4 v[48:51], v128, s[52:53] sc1
global_load_dwordx4 v[52:55], v128, s[52:53] offset:1024 sc1
global_load_dwordx4 v[56:59], v128, s[52:53] offset:2048 sc1
global_load_dwordx4 v[60:63], v128, s[52:53] offset:3072 sc1
s_waitcnt vmcnt(4)
global_load_dwordx4 v[64:67], v3, s[52:53] sc1
global_load_dwordx4 v[68:71], v3, s[52:53] offset:1024 sc1
global_load_dwordx4 v[72:75], v3, s[52:53] offset:2048 sc1
global_load_dwordx4 v[76:79], v3, s[52:53] offset:3072 sc1
global_load_dwordx4 v[80:83], v128, s[52:53] sc1
global_load_dwordx4 v[84:87], v128, s[52:53] offset:1024 sc1
global_load_dwordx4 v[88:91], v128, s[52:53] offset:2048 sc1
global_load_dwordx4 v[92:95], v128, s[52:53] offset:3072 sc1
L_c_q:
s_waitcnt vmcnt(8)
v_xor_b32 v16, s33, v34
v_bitop3_b32 v16, v35, s92, v16 bitop3:0xbe
v_bitop3_b32 v16, v38, s33, v16 bitop3:0xbe
v_bitop3_b32 v16, v39, s92, v16 bitop3:0xbe
v_bitop3_b32 v16, v42, s33, v16 bitop3:0xbe
v_bitop3_b32 v16, v43, s92, v16 bitop3:0xbe
v_bitop3_b32 v16, v46, s33, v16 bitop3:0xbe
v_bitop3_b32 v16, v47, s92, v16 bitop3:0xbe
v_bitop3_b32 v16, v50, s33, v16 bitop3:0xbe
v_bitop3_b32 v16, v51, s92, v16 bitop3:0xbe
v_bitop3_b32 v16, v54, s33, v16 bitop3:0xbe
v_bitop3_b32 v16, v55, s92, v16 bitop3:0xbe
v_bitop3_b32 v16, v58, s33, v16 bitop3:0xbe
v_bitop3_b32 v16, v59, s92, v16 bitop3:0xbe
v_bitop3_b32 v16, v62, s33, v16 bitop3:0xbe
v_bitop3_b32 v16, v63, s92, v16 bitop3:0xbe
v_cmp_ne_u32 vcc, 0, v16
s_cbranch_vccz L_c_q_ok0
global_load_dwordx4 v[32:35], v3, s[52:53] sc1
global_load_dwordx4 v[36:39], v3, s[52:53] offset:1024 sc1
global_load_dwordx4 v[40:43], v3, s[52:53] offset:2048 sc1
global_load_dwordx4 v[44:47], v3, s[52:53] offset:3072 sc1
global_load_dwordx4 v[48:51], v128, s[52:53] sc1
global_load_dwordx4 v[52:55], v128, s[52:53] offset:1024 sc1
global_load_dwordx4 v[56:59], v128, s[52:53] offset:2048 sc1
global_load_dwordx4 v[60:63], v128, s[52:53] offset:3072 sc1
s_waitcnt vmcnt(8)
v_xor_b32 v16, s33, v66
v_bitop3_b32 v16, v67, s92, v16 bitop3:0xbe
v_bitop3_b32 v16, v70, s33, v16 bitop3:0xbe
v_bitop3_b32 v16, v71, s92, v16 bitop3:0xbe
v_bitop3_b32 v16, v74, s33, v16 bitop3:0xbe
v_bitop3_b32 v16, v75, s92, v16 bitop3:0xbe
v_bitop3_b32 v16, v78, s33, v16 bitop3:0xbe
v_bitop3_b32 v16, v79, s92, v16 bitop3:0xbe
v_bitop3_b32 v16, v82, s33, v16 bitop3:0xbe
v_bitop3_b32 v16, v83, s92, v16 bitop3:0xbe
v_bitop3_b32 v16, v86, s33, v16 bitop3:0xbe
v_bitop3_b32 v16, v87, s92, v16 bitop3:0xbe
v_bitop3_b32 v16, v90, s33, v16 bitop3:0xbe
v_bitop3_b32 v16, v91, s92, v16 bitop3:0xbe
v_bitop3_b32 v16, v94, s33, v16 bitop3:0xbe
v_bitop3_b32 v16, v95, s92, v16 bitop3:0xbe
v_cmp_ne_u32 vcc, 0, v16
s_cbranch_vccz L_c_q_ok1
global_load_dwordx4 v[64:67], v3, s[52:53] sc1
global_load_dwordx4 v[68:71], v3, s[52:53] offset:1024 sc1
global_load_dwordx4 v[72:75], v3, s[52:53] offset:2048 sc1
global_load_dwordx4 v[76:79], v3, s[52:53] offset:3072 sc1
global_load_dwordx4 v[80:83], v128, s[52:53] sc1
global_load_dwordx4 v[84:87], v128, s[52:53] offset:1024 sc1
global_load_dwordx4 v[88:91], v128, s[52:53] offset:2048 sc1
global_load_dwordx4 v[92:95], v128, s[52:53] offset:3072 sc1
s_add_u32 s50, s50, 1
s_cmp_eq_u32 s50, 24
s_cbranch_scc0 L_c_q_n
s_add_u32 s52, s52, 1830912
s_addc_u32 s53, s53, 0
L_c_q_n:
s_cmp_lt_u32 s50, 0x80000
s_cbranch_scc1 L_c_q
s_branch L_c_q_ok0
L_c_q_ok1:
v_pk_add_f32 v[64:65], v[64:65], v[80:81]
v_pk_add_f32 v[68:69], v[68:69], v[84:85]
v_pk_add_f32 v[72:73], v[72:73], v[88:89]
v_pk_add_f32 v[76:77], v[76:77], v[92:93]
v_cvt_pk_bf16_f32 v20, v64, v65
v_cvt_pk_bf16_f32 v21, v68, v69
v_cvt_pk_bf16_f32 v22, v72, v73
v_cvt_pk_bf16_f32 v23, v76, v77
ds_write_b32 v129, v20 offset:1024
ds_write_b32 v129, v21 offset:1296
ds_write_b32 v129, v22 offset:1568
ds_write_b32 v129, v23 offset:1840
s_branch L_c_q_done
L_c_q_ok0:
v_pk_add_f32 v[32:33], v[32:33], v[48:49]
v_pk_add_f32 v[36:37], v[36:37], v[52:53]
v_pk_add_f32 v[40:41], v[40:41], v[56:57]
v_pk_add_f32 v[44:45], v[44:45], v[60:61]
v_cvt_pk_bf16_f32 v20, v32, v33
v_cvt_pk_bf16_f32 v21, v36, v37
v_cvt_pk_bf16_f32 v22, v40, v41
v_cvt_pk_bf16_f32 v23, v44, v45
ds_write_b32 v129, v20 offset:1024
ds_write_b32 v129, v21 offset:1296
ds_write_b32 v129, v22 offset:1568
ds_write_b32 v129, v23 offset:1840
L_c_q_done:
s_waitcnt lgkmcnt(0)
ds_write_b32 v10, v11 offset:8
s_waitcnt vmcnt(0)
v_mov_b32 v51, 0xfffff000
s_cmp_ge_u32 s31, 16
s_cbranch_scc1 L_c_nog
v_and_b32 v10, 7, v1
v_lshlrev_b32 v11, 2, v10
v_lshlrev_b32 v10, 4, v10
s_mov_b32 s50, 0
L_c_gw:
ds_read_b32 v36, v11 offset:3584
s_add_u32 s50, s50, 1
s_cmp_gt_u32 s50, 0x400000
s_cbranch_scc1 L_c_gwx
s_waitcnt lgkmcnt(0)
v_cmp_eq_u32 vcc, -1, v36
s_cbranch_vccnz L_c_gw
L_c_gwx:
ds_read_b128 v[32:35], v10 offset:2192
s_waitcnt lgkmcnt(0)
v_add_f32_dpp v32, v32, v32 quad_perm:[1,0,3,2] row_mask:0xf bank_mask:0xf
v_add_f32_dpp v33, v33, v33 quad_perm:[1,0,3,2] row_mask:0xf bank_mask:0xf
v_add_f32_dpp v34, v34, v34 quad_perm:[1,0,3,2] row_mask:0xf bank_mask:0xf
v_add_f32_dpp v35, v35, v35 quad_perm:[1,0,3,2] row_mask:0xf bank_mask:0xf
v_add_f32_dpp v32, v32, v32 quad_perm:[2,3,0,1] row_mask:0xf bank_mask:0xf
v_add_f32_dpp v33, v33, v33 quad_perm:[2,3,0,1] row_mask:0xf bank_mask:0xf
v_add_f32_dpp v34, v34, v34 quad_perm:[2,3,0,1] row_mask:0xf bank_mask:0xf
v_add_f32_dpp v35, v35, v35 quad_perm:[2,3,0,1] row_mask:0xf bank_mask:0xf
v_add_f32_dpp v32, v32, v32 row_half_mirror row_mask:0xf bank_mask:0xf
v_add_f32_dpp v33, v33, v33 row_half_mirror row_mask:0xf bank_mask:0xf
v_add_f32_dpp v34, v34, v34 row_half_mirror row_mask:0xf bank_mask:0xf
v_add_f32_dpp v35, v35, v35 row_half_mirror row_mask:0xf bank_mask:0xf
s_lshl_b32 s39, s39, 16
v_cvt_pk_bf16_f32 v36, v32, v33
v_cvt_pk_bf16_f32 v37, v34, v35
v_lshlrev_b32 v32, 16, v36
v_and_b32 v33, 0xffff0000, v36
v_lshlrev_b32 v34, 16, v37
v_and_b32 v35, 0xffff0000, v37
v_add_f32 v32, s39, v32
v_add_f32 v33, s39, v33
v_add_f32 v34, s39, v34
v_add_f32 v35, s39, v35
v_cvt_pk_bf16_f32 v36, v32, v33
v_cvt_pk_bf16_f32 v37, v34, v35
v_lshlrev_b32 v32, 16, v36
v_and_b32 v33, 0xffff0000, v36
v_lshlrev_b32 v34, 16, v37
v_and_b32 v35, 0xffff0000, v37
v_mul_f32 v36, 0xbfb8aa3b, v32
v_mul_f32 v37, 0xbfb8aa3b, v33
v_mul_f32 v38, 0xbfb8aa3b, v34
v_mul_f32 v39, 0xbfb8aa3b, v35
v_exp_f32 v36, v36
v_exp_f32 v37, v37
v_exp_f32 v38, v38
v_exp_f32 v39, v39
v_add_f32 v36, 1.0, v36
v_add_f32 v37, 1.0, v37
v_add_f32 v38, 1.0, v38
v_add_f32 v39, 1.0, v39
v_rcp_f32 v36, v36
v_rcp_f32 v37, v37
v_rcp_f32 v38, v38
v_rcp_f32 v39, v39
v_mul_f32 v36, v32, v36
v_mul_f32 v37, v33, v37
v_mul_f32 v38, v34, v38
v_mul_f32 v39, v35, v39
v_cvt_pk_bf16_f32 v60, v36, v37
v_cvt_pk_bf16_f32 v61, v38, v39
v_lshlrev_b32 v56, 16, v60
v_and_b32 v57, 0xffff0000, v60
v_lshlrev_b32 v58, 16, v61
v_and_b32 v59, 0xffff0000, v61
s_lshl_b32 s58, s56, 16
s_and_b32 s56, s56, 0xffff0000
s_lshl_b32 s59, s57, 16
s_and_b32 s57, s57, 0xffff0000
s_lshl_b32 s40, s51, 3
v_mov_b32 v62, v56
v_mov_b32 v63, s58
v_mov_b32 v55, s40
s_mov_b32 exec_lo, 0xffff0000
s_mov_b32 exec_hi, 0x0
v_mov_b32 v62, v58
v_mov_b32 v63, s59
v_add_u32 v55, 4, v55
s_mov_b32 exec_lo, 0x0
s_mov_b32 exec_hi, 0xffff
v_mov_b32 v62, v57
v_mov_b32 v63, s56
v_add_u32 v55, 2, v55
s_mov_b32 exec_lo, 0x0
s_mov_b32 exec_hi, 0xffff0000
v_mov_b32 v62, v59
v_mov_b32 v63, s57
v_add_u32 v55, 6, v55
s_mov_b64 exec, -1
L_c_nog:
s_lshr_b32 s40, s31, 3
s_and_b32 s41, s31, 7
s_lshl_b32 s42, s40, 6
s_lshl_b32 s41, s41, 8
s_add_u32 s42, s42, s41
s_lshl_b32 s40, s40, 4
s_add_u32 s40, s40, 2048
v_mul_u32_u24 v10, 2176, v9
v_add_u32 v11, s40, v10
v_lshl_add_u32 v10, v8, 4, v10
v_add_u32 v10, s42, v10
v_add_u32 v4, 34816, v10
v_add_u32 v5, 34816, v11
s_mul_i32 s40, s30, 69632
s_add_u32 s40, s40, 131072
s_add_u32 s52, s28, s40
s_addc_u32 s53, s29, 0
v_bfe_u32 v54, v9, 2, 1
v_lshlrev_b32 v54, 1, v54
v_bfe_u32 v50, v9, 3, 1
v_or_b32 v54, v54, v50
v_lshl_add_u32 v54, v8, 2, v54
v_lshlrev_b32 v54, 1, v54
s_barrier
s_mov_b32 s50, 0
s_mov_b32 s59, 0
s_mov_b64 s[80:81], -1
s_mov_b64 s[82:83], -1
s_mov_b64 s[84:85], -1
s_mov_b64 s[86:87], -1
L_c_o:
s_mov_b64 exec, s[80:81]
s_cbranch_execz L_c_o_s0
global_load_dwordx4 v[32:35], v10, s[52:53] sc1
L_c_o_s0:
s_mov_b64 exec, s[82:83]
s_cbranch_execz L_c_o_s1
global_load_dwordx4 v[36:39], v4, s[52:53] sc1
L_c_o_s1:
s_mov_b64 exec, s[84:85]
s_cbranch_execz L_c_o_s2
global_load_dwordx4 v[40:43], v11, s[52:53] sc1
L_c_o_s2:
s_mov_b64 exec, s[86:87]
s_cbranch_execz L_c_o_s3
global_load_dwordx4 v[44:47], v5, s[52:53] sc1
L_c_o_s3:
s_mov_b64 exec, -1
s_add_u32 s50, s50, 1
s_cmp_lg_u32 s59, 1
s_cbranch_scc1 L_c_o_nw
v_and_b32 v40, v51, v40
v_and_b32 v41, v51, v41
v_and_b32 v44, v51, v44
v_and_b32 v45, v51, v45
v_max_f32 v50, v40, v44
s_nop 1
v_max_f32_dpp v50, v50, v50 row_ror:1 row_mask:0xf bank_mask:0xf
s_nop 1
v_max_f32_dpp v50, v50, v50 row_ror:2 row_mask:0xf bank_mask:0xf
s_nop 1
v_max_f32_dpp v50, v50, v50 row_ror:4 row_mask:0xf bank_mask:0xf
s_nop 1
v_max_f32_dpp v50, v50, v50 row_ror:8 row_mask:0xf bank_mask:0xf
v_sub_f32 v52, v40, v50
v_sub_f32 v53, v44, v50
v_mul_f32 v52, 0x3fb8aa3b, v52
v_mul_f32 v53, 0x3fb8aa3b, v53
v_exp_f32 v52, v52
v_exp_f32 v53, v53
v_mul_f32 v50, v52, v41
v_fmac_f32 v50, v53, v45
s_nop 1
v_add_f32_dpp v50, v50, v50 row_ror:1 row_mask:0xf bank_mask:0xf
s_nop 1
v_add_f32_dpp v50, v50, v50 row_ror:2 row_mask:0xf bank_mask:0xf
s_nop 1
v_add_f32_dpp v50, v50, v50 row_ror:4 row_mask:0xf bank_mask:0xf
s_nop 1
v_add_f32_dpp v50, v50, v50 row_ror:8 row_mask:0xf bank_mask:0xf
v_rcp_f32 v50, v50
s_nop 0
v_mul_f32 v52, v50, v52
v_mul_f32 v53, v50, v53
s_mov_b32 s59, 2
L_c_o_nw:
s_waitcnt vmcnt(0)
v_perm_b32 v48, v33, v32, s48
v_perm_b32 v49, v35, v34, s48
v_bitop3_b32 v48, v48, v130, s94 bitop3:0x6a
v_bitop3_b32 v49, v49, v130, s95 bitop3:0x6a
v_or_b32 v48, v48, v49
v_cmp_ne_u32 s[80:81], 0, v48
v_perm_b32 v48, v37, v36, s48
v_perm_b32 v49, v39, v38, s48
v_bitop3_b32 v48, v48, v130, s94 bitop3:0x6a
v_bitop3_b32 v49, v49, v130, s95 bitop3:0x6a
v_or_b32 v48, v48, v49
v_cmp_ne_u32 s[82:83], 0, v48
s_cmp_lg_u32 s59, 0
s_cbranch_scc1 L_c_o_nc
v_perm_b32 v48, v41, v40, s48
v_perm_b32 v49, v43, v42, s48
v_bitop3_b32 v48, v48, v130, s94 bitop3:0x6a
v_bitop3_b32 v49, v49, v130, s95 bitop3:0x6a
v_or_b32 v48, v48, v49
v_cmp_ne_u32 s[84:85], 0, v48
v_perm_b32 v48, v45, v44, s48
v_perm_b32 v49, v47, v46, s48
v_bitop3_b32 v48, v48, v130, s94 bitop3:0x6a
v_bitop3_b32 v49, v49, v130, s95 bitop3:0x6a
v_or_b32 v48, v48, v49
v_cmp_ne_u32 s[86:87], 0, v48
s_nop 0
s_or_b64 s[88:89], s[84:85], s[86:87]
s_cselect_b32 s59, 0, 1
L_c_o_nc:
s_or_b64 s[88:89], s[80:81], s[82:83]
s_or_b64 s[90:91], s[84:85], s[86:87]
s_or_b64 s[88:89], s[88:89], s[90:91]
s_cbranch_scc0 L_c_o_ok
s_cmp_eq_u32 s50, 24
s_cbranch_scc0 L_c_o_n
s_add_u32 s52, s52, 589824
s_addc_u32 s53, s53, 0
L_c_o_n:
s_cmp_lt_u32 s50, 0x100000
s_cbranch_scc1 L_c_o
L_c_o_ok:
s_cmp_eq_u32 s59, 2
s_cbranch_scc1 L_c_o_wd
v_and_b32 v40, v51, v40
v_and_b32 v41, v51, v41
v_and_b32 v44, v51, v44
v_and_b32 v45, v51, v45
v_max_f32 v50, v40, v44
s_nop 1
v_max_f32_dpp v50, v50, v50 row_ror:1 row_mask:0xf bank_mask:0xf
s_nop 1
v_max_f32_dpp v50, v50, v50 row_ror:2 row_mask:0xf bank_mask:0xf
s_nop 1
v_max_f32_dpp v50, v50, v50 row_ror:4 row_mask:0xf bank_mask:0xf
s_nop 1
v_max_f32_dpp v50, v50, v50 row_ror:8 row_mask:0xf bank_mask:0xf
v_sub_f32 v52, v40, v50
v_sub_f32 v53, v44, v50
v_mul_f32 v52, 0x3fb8aa3b, v52
v_mul_f32 v53, 0x3fb8aa3b, v53
v_exp_f32 v52, v52
v_exp_f32 v53, v53
v_mul_f32 v50, v52, v41
v_fmac_f32 v50, v53, v45
s_nop 1
v_add_f32_dpp v50, v50, v50 row_ror:1 row_mask:0xf bank_mask:0xf
s_nop 1
v_add_f32_dpp v50, v50, v50 row_ror:2 row_mask:0xf bank_mask:0xf
s_nop 1
v_add_f32_dpp v50, v50, v50 row_ror:4 row_mask:0xf bank_mask:0xf
s_nop 1
v_add_f32_dpp v50, v50, v50 row_ror:8 row_mask:0xf bank_mask:0xf
v_rcp_f32 v50, v50
s_nop 0
v_mul_f32 v52, v50, v52
v_mul_f32 v53, v50, v53
L_c_o_wd:
v_and_b32 v32, v51, v32
v_and_b32 v33, v51, v33
v_and_b32 v34, v51, v34
v_and_b32 v35, v51, v35
v_and_b32 v36, v51, v36
v_and_b32 v37, v51, v37
v_and_b32 v38, v51, v38
v_and_b32 v39, v51, v39
v_mul_f32 v32, v52, v32
v_mul_f32 v33, v52, v33
v_mul_f32 v34, v52, v34
v_mul_f32 v35, v52, v35
v_fmac_f32 v32, v53, v36
v_fmac_f32 v33, v53, v37
v_fmac_f32 v34, v53, v38
v_fmac_f32 v35, v53, v39
v_add_f32_dpp v36, v32, v32 row_ror:8 row_mask:0xf bank_mask:0x3
v_add_f32_dpp v37, v34, v34 row_ror:8 row_mask:0xf bank_mask:0x3
s_nop 0
v_add_f32_dpp v36, v33, v33 row_ror:8 row_mask:0xf bank_mask:0xc
v_add_f32_dpp v37, v35, v35 row_ror:8 row_mask:0xf bank_mask:0xc
s_nop 0
v_add_f32_dpp v38, v36, v36 row_shl:4 row_mask:0xf bank_mask:0x5
s_nop 1
v_add_f32_dpp v38, v37, v37 row_shr:4 row_mask:0xf bank_mask:0xa
s_nop 1
v_add_f32_dpp v38, v38, v38 quad_perm:[1,0,3,2] row_mask:0xf bank_mask:0xf
s_nop 1
v_add_f32_dpp v38, v38, v38 quad_perm:[2,3,0,1] row_mask:0xf bank_mask:0xf
v_cvt_pk_bf16_f32 v38, v38, v38
s_mov_b32 exec_lo, 0x11111111
s_mov_b32 exec_hi, 0x11111111
ds_write_b16 v54, v38 offset:2112
s_mov_b64 exec, -1
s_lshl_b32 s40, s51, 4
v_lshlrev_b32 v4, 11, v1
s_add_u32 s40, s40, 1310720
s_add_u32 s52, s28, s40
s_addc_u32 s53, s29, 0
v_add_u32 v5, 131072, v4
v_add_u32 v6, 262144, v4
v_add_u32 v7, 393216, v4
s_waitcnt lgkmcnt(0)
s_barrier
s_cmp_ge_u32 s31, 16
s_cbranch_scc1 L_c_end
v_mov_b32 v10, 2184
s_mov_b32 s50, 0
L_c_hw:
ds_read_b32 v11, v10
s_add_u32 s50, s50, 1
s_cmp_gt_u32 s50, 0x400000
s_cbranch_scc1 L_c_hwx
s_waitcnt lgkmcnt(0)
v_cmp_ne_u32 vcc, 8, v11
s_cbranch_vccnz L_c_hw
L_c_hwx:
s_mov_b32 s50, 0
s_mov_b64 s[80:81], -1
s_mov_b64 s[82:83], -1
s_mov_b64 s[84:85], -1
s_mov_b64 s[86:87], -1
L_c_f:
s_mov_b64 exec, s[80:81]
s_cbranch_execz L_c_f_s0
global_load_dwordx4 v[32:35], v4, s[52:53] sc1
L_c_f_s0:
s_mov_b64 exec, s[82:83]
s_cbranch_execz L_c_f_s1
global_load_dwordx4 v[36:39], v5, s[52:53] sc1
L_c_f_s1:
s_mov_b64 exec, s[84:85]
s_cbranch_execz L_c_f_s2
global_load_dwordx4 v[40:43], v6, s[52:53] sc1
L_c_f_s2:
s_mov_b64 exec, s[86:87]
s_cbranch_execz L_c_f_s3
global_load_dwordx4 v[44:47], v7, s[52:53] sc1
L_c_f_s3:
s_mov_b64 exec, -1
s_add_u32 s50, s50, 1
s_waitcnt vmcnt(0)
v_perm_b32 v48, v33, v32, s48
v_perm_b32 v49, v35, v34, s48
v_bitop3_b32 v48, v48, v130, s94 bitop3:0x6a
v_bitop3_b32 v49, v49, v130, s95 bitop3:0x6a
v_or_b32 v48, v48, v49
v_cmp_ne_u32 s[80:81], 0, v48
v_perm_b32 v48, v37, v36, s48
v_perm_b32 v49, v39, v38, s48
v_bitop3_b32 v48, v48, v130, s94 bitop3:0x6a
v_bitop3_b32 v49, v49, v130, s95 bitop3:0x6a
v_or_b32 v48, v48, v49
v_cmp_ne_u32 s[82:83], 0, v48
v_perm_b32 v48, v41, v40, s48
v_perm_b32 v49, v43, v42, s48
v_bitop3_b32 v48, v48, v130, s94 bitop3:0x6a
v_bitop3_b32 v49, v49, v130, s95 bitop3:0x6a
v_or_b32 v48, v48, v49
v_cmp_ne_u32 s[84:85], 0, v48
v_perm_b32 v48, v45, v44, s48
v_perm_b32 v49, v47, v46, s48
v_bitop3_b32 v48, v48, v130, s94 bitop3:0x6a
v_bitop3_b32 v49, v49, v130, s95 bitop3:0x6a
v_or_b32 v48, v48, v49
v_cmp_ne_u32 s[86:87], 0, v48
s_or_b64 s[88:89], s[80:81], s[82:83]
s_or_b64 s[90:91], s[84:85], s[86:87]
s_or_b64 s[88:89], s[88:89], s[90:91]
s_cbranch_scc0 L_c_f_ok
s_cmp_lt_u32 s50, 0x100000
s_cbranch_scc1 L_c_f
L_c_f_ok:
v_and_b32 v32, v51, v32
v_and_b32 v33, v51, v33
v_and_b32 v34, v51, v34
v_and_b32 v35, v51, v35
v_and_b32 v36, v51, v36
v_and_b32 v37, v51, v37
v_and_b32 v38, v51, v38
v_and_b32 v39, v51, v39
v_and_b32 v40, v51, v40
v_and_b32 v41, v51, v41
v_and_b32 v42, v51, v42
v_and_b32 v43, v51, v43
v_and_b32 v44, v51, v44
v_and_b32 v45, v51, v45
v_and_b32 v46, v51, v46
v_and_b32 v47, v51, v47
v_pk_add_f32 v[32:33], v[32:33], v[36:37]
v_pk_add_f32 v[34:35], v[34:35], v[38:39]
v_pk_add_f32 v[40:41], v[40:41], v[44:45]
v_pk_add_f32 v[42:43], v[42:43], v[46:47]
v_pk_add_f32 v[32:33], v[32:33], v[40:41]
v_pk_add_f32 v[34:35], v[34:35], v[42:43]
s_nop 0
v_permlane32_swap_b32 v32, v33
v_permlane32_swap_b32 v34, v35
v_add_f32 v32, v32, v33
v_add_f32 v34, v34, v35
s_nop 1
v_permlane16_swap_b32 v32, v34
v_add_f32 v32, v32, v34
s_nop 1
v_add_f32_dpp v32, v32, v32 row_ror:1 row_mask:0xf bank_mask:0xf
s_nop 1
v_add_f32_dpp v32, v32, v32 row_ror:2 row_mask:0xf bank_mask:0xf
s_nop 1
v_add_f32_dpp v32, v32, v32 row_ror:4 row_mask:0xf bank_mask:0xf
s_nop 1
v_add_f32_dpp v32, v32, v32 row_ror:8 row_mask:0xf bank_mask:0xf
v_cvt_pk_bf16_f32 v32, v32, v32
v_and_b32 v32, 0xffff0000, v32
v_mul_f32 v32, v62, v32
v_cvt_pk_bf16_f32 v32, v32, v32
v_and_b32 v32, 0xffff0000, v32
v_add_f32 v32, v63, v32
v_cvt_pk_bf16_f32 v32, v32, v32
s_mov_b32 exec_lo, 0x10001
s_mov_b32 exec_hi, 0x10001
global_store_short v55, v32, s[24:25]
s_cmp_lg_u32 s51, 0
s_cbranch_scc1 L_c_noep
v_mov_b32 v11, s33
v_mov_b32 v10, 0
global_store_dword v10, v11, s[28:29] sc1
L_c_noep:
s_mov_b64 exec, -1
L_c_end:
L_end:
s_endpgm
.section .rodata,"a"
.p2align 6
.amdhsa_kernel recurrent_scan__sliding_block_cached__mixer_token_mlp__decode_kernel
  .amdhsa_next_free_vgpr 136
  .amdhsa_next_free_sgpr 96
  .amdhsa_accum_offset 136
  .amdhsa_group_segment_fixed_size 0
  .amdhsa_kernarg_size 104
  .amdhsa_user_sgpr_count 2
  .amdhsa_user_sgpr_kernarg_segment_ptr 1
  .amdhsa_system_sgpr_workgroup_id_x 1
  .amdhsa_float_denorm_mode_32 3
.end_amdhsa_kernel
```
